```python
import torch

def _softmax(x, axis=-1):
    return torch.softmax(x, dim=axis)
def _gelu(x):
    return torch.nn.functional.gelu(x, approximate="tanh")
def _silu(x):
    return torch.nn.functional.silu(x)
def _sigmoid(x):
    return torch.sigmoid(x)
def _layernorm(x, axis=-1, eps=1e-5):
    m = x.mean(dim=axis, keepdim=True)
    v = x.var(dim=axis, keepdim=True, unbiased=False)
    return (x - m) / torch.sqrt(v + eps)
def _scatter_add(tgt, idx, src, axis=0):
    return tgt.clone().index_add_(axis, idx, src)
def _segment_sum(src, seg, n):
    out = torch.zeros((n,) + src.shape[1:], dtype=src.dtype)
    return out.index_add_(0, seg, src)
def _pad(x, pw):
    flat = tuple(v for pair in reversed(pw) for v in pair)
    return torch.nn.functional.pad(x, flat)

kernel_name = 'parallel_sum__sliding_block_cached__swiglu_ffn__decode'

def setup_inputs():

    _w = (lambda a: (lambda t: t.to(torch.bfloat16) if t.is_floating_point() else t)(torch.as_tensor(a)))
    def _A_setup():
        B, Sq, D = 1, 1, 512
        Hq, Hkv, Sk, Dh = 32, 8, 65536, 128
        assert Hq % Hkv == 0, (Hq, Hkv)
        return {
            "x": _w((lambda *s: torch.randn(*s, dtype=torch.bfloat16) * 0.05)(B, Sq, D)),
            "k_cache": _w((lambda *s: torch.randn(*s, dtype=torch.bfloat16) * 3.2)(B, Hkv, Sk, Dh)),
            "v_cache": _w((lambda *s: torch.randn(*s, dtype=torch.bfloat16) * 1.6)(B, Hkv, Sk, Dh)),
            "wq": _w((lambda *s: torch.randn(*s, dtype=torch.bfloat16) * 3.2)(D, Hq * Dh) * (D ** -0.5)),
            "wo": _w((lambda *s: torch.randn(*s, dtype=torch.bfloat16) * 1.6)(Hq * Dh, D) * ((Hq * Dh) ** -0.5)),
        }
    _A_in = _A_setup()

    def _B_setup():
        B, S, D, F = 1, 1, 512, 1792
        return {
            "x": _w((lambda *s: torch.randn(*s, dtype=torch.bfloat16) * 0.05)(B, S, D)),
            "w_gate": _w((lambda *s: torch.randn(*s, dtype=torch.bfloat16) * 0.05)(D, F)),
            "w_up": _w((lambda *s: torch.randn(*s, dtype=torch.bfloat16) * 0.05)(D, F)),
            "w_down": _w((lambda *s: torch.randn(*s, dtype=torch.bfloat16) * 0.05)(F, D)),
        }
    _B_in = _B_setup()

    return {
        "A_x": _A_in["x"],
        "A_k_cache": _A_in["k_cache"],
        "A_v_cache": _A_in["v_cache"],
        "A_wq": _A_in["wq"],
        "A_wo": _A_in["wo"],
        "B_x": _B_in["x"],
        "B_w_gate": _B_in["w_gate"],
        "B_w_up": _B_in["w_up"],
        "B_w_down": _B_in["w_down"],
    }

def reference(A_x, A_k_cache, A_v_cache, A_wq, A_wo, B_x, B_w_gate, B_w_up, B_w_down):
    def _A_ref(x, k_cache, v_cache, wq, wo):
        B, Sq, D = x.shape
        Hq, Dh = 32, 128
        Hkv, Sk = k_cache.shape[1], k_cache.shape[2]
        W = min(4096, max(256, Sk // 4))
        rep = Hq // Hkv
        q = (lambda x, *d: x.permute(*d))((x @ wq).reshape(B, Sq, Hq, Dh), 0, 2, 1, 3)
        k = (lambda x, n, axis: torch.repeat_interleave(x, n, dim=axis))(k_cache[:, :, Sk - W:, :], rep, axis=1)
        v = (lambda x, n, axis: torch.repeat_interleave(x, n, dim=axis))(v_cache[:, :, Sk - W:, :], rep, axis=1)
        scores = torch.einsum("bhqd,bhkd->bhqk", q, k) * (Dh ** -0.5)
        p = _softmax(scores, axis=-1)
        o = torch.einsum("bhqk,bhkd->bhqd", p, v)
        return (lambda x, *d: x.permute(*d))(o, 0, 2, 1, 3).reshape(B, Sq, Hq * Dh) @ wo

    def _B_ref(x, w_gate, w_up, w_down):
        g = _silu(x @ w_gate)
        u = x @ w_up
        return (g * u) @ w_down

    x = A_x
    xn = _layernorm(x, axis=-1)
    return x + _A_ref(xn, A_k_cache, A_v_cache, A_wq, A_wo) + _B_ref(xn, B_w_gate, B_w_up, B_w_down)
```

```asm
; @launch grid=(256,1,1) block=(320,1,1) lds=76800
.amdgcn_target "amdgcn-amd-amdhsa--gfx950"
.text
.globl parallel_sum__sliding_block_cached__swiglu_ffn__decode_kernel
.p2align 8
.type parallel_sum__sliding_block_cached__swiglu_ffn__decode_kernel,@function
parallel_sum__sliding_block_cached__swiglu_ffn__decode_kernel:
    s_cmp_ge_u32 s2, 256
    s_cbranch_scc1 L_end
    s_load_dwordx16 s[4:19], s[0:1], 0
    s_load_dwordx8 s[20:27], s[0:1], 64
    v_lshrrev_b32 v1, 6, v0
    v_and_b32 v0, 63, v0
    v_readfirstlane_b32 s30, v1
    s_and_b32 s31, s2, 7
    s_lshr_b32 s32, s2, 3
    s_cmp_eq_u32 s30, 4
    s_cbranch_scc0 L_race
    s_setprio 3
    s_getpc_b64 s[28:29]
L_pc:
    v_lshlrev_b32 v2, 7, v0
    v_min_u32 v2, L_end-L_pc-448, v2
    global_load_dword v127, v2, s[28:29] offset:448
    v_lshlrev_b32 v3, 4, v0
    v_lshrrev_b32 v6, 3, v0
    v_and_b32 v5, 2, v6
    v_and_b32 v7, 7, v0
    v_xor_b32 v5, v5, v7
    v_lshlrev_b32 v7, 4, v5
    s_and_b32 s50, s32, 3
    s_lshl_b32 s37, s31, 10
    s_lshr_b32 s55, s32, 2
    s_lshl_b32 s38, s55, 7
    s_lshl_b32 s39, s50, 20
    s_add_u32 s37, s37, s38
    s_add_u32 s37, s37, s39
    v_lshl_add_u32 v4, v6, 13, v7
    v_add_u32 v4, s37, v4
    v_xor_b32 v5, 64, v4
    v_add_u32 v5, 0x10000, v5
    s_mov_b32 m0, 0
    s_mov_b32 s38, 0x20000
    s_movk_i32 s41, 1024
    s_waitcnt lgkmcnt(0)
    global_load_dwordx4 v[8:11], v3, s[4:5]
    s_load_dword s33, s[26:27], 0
    s_mov_b32 s39, 8
L_wq_loop:
    global_load_lds_dwordx4 v4, s[10:11] nt
    s_add_u32 m0, m0, s41
    v_add_u32 v4, s38, v4
    global_load_lds_dwordx4 v5, s[10:11] nt
    s_add_u32 m0, m0, s41
    v_add_u32 v5, s38, v5
    s_sub_u32 s39, s39, 1
    s_cmp_lg_u32 s39, 0
    s_cbranch_scc1 L_wq_loop
    s_lshl_b32 s37, s31, 2
    s_lshr_b32 s40, 0x33221100, s37
    s_and_b32 s40, s40, 7
    s_sub_u32 s3, s37, s40
    s_lshr_b32 s40, 0x10101010, s37
    s_and_b32 s40, s40, 7
    s_lshr_b32 s38, s32, 3
    s_add_u32 s37, s3, s38
    s_add_u32 s51, s38, s40
    s_mul_i32 s38, s50, 3584
    s_add_u32 s37, s37, s38
    s_lshl_b32 s37, s37, 7
    v_mul_u32_u24 v4, 3584, v6
    v_add3_u32 v4, v4, v7, s37
    v_xor_b32 v5, 64, v4
    v_add_u32 v5, 28672, v5
    s_mov_b32 s38, 57344
    s_bitcmp0_b32 s32, 2
    s_cselect_b64 s[42:43], s[16:17], s[18:19]
    s_cmp_ge_u32 s51, 4
    s_cselect_b64 exec, 1, -1
    s_mov_b32 s39, 8
L_ff_loop:
    global_load_lds_dwordx4 v4, s[42:43] nt
    s_add_u32 m0, m0, s41
    v_add_u32 v4, s38, v4
    global_load_lds_dwordx4 v5, s[42:43] nt
    s_add_u32 m0, m0, s41
    v_add_u32 v5, s38, v5
    s_sub_u32 s39, s39, 1
    s_cmp_lg_u32 s39, 0
    s_cbranch_scc1 L_ff_loop
    s_mov_b64 exec, -1
    s_branch L_unit2
L_race:
    s_lshl_b32 s37, s2, 2
    s_add_u32 s37, s37, s30
    s_lshr_b32 s38, s37, 6
    s_lshl_b32 s38, s38, 14
    s_and_b32 s37, s37, 63
    s_lshl_b32 s37, s37, 7
    s_add_u32 s37, s37, s38
    s_or_b32 s37, s37, 0x1c0000
    s_lshl_b32 s38, s30, 13
    s_and_b32 s38, s38, 0x2000
    s_or_b32 s46, s37, s38
    s_xor_b32 s47, s46, 0x2000
    s_waitcnt lgkmcnt(0)
    s_load_dword s58, s[26:27], s46
    s_load_dwordx2 s[28:29], s[26:27], s47
    s_waitcnt lgkmcnt(2)
    s_getreg_b32 s39, hwreg(HW_REG_IB_STS, 8, 4)
L_race_done:
    s_lshr_b32 s37, s39, 1
    s_and_b32 s39, s39, 1
    s_sub_i32 s37, s37, s39
    s_sub_i32 s39, 0, s37
    s_cmp_eq_u32 s38, 0
    s_cselect_b32 s37, s37, s39
    s_lshl_b32 s39, s30, 2
    v_mov_b32 v158, s39
    v_mov_b32 v159, s37
    ds_write_b32 v158, v159 offset:34864
    s_branch L_attn
    s_endpgm
    s_endpgm
    s_endpgm
    s_endpgm
L_unit2:
    s_lshl_b32 s37, s31, 15
    s_lshl_b32 s38, s32, 8
    s_add_u32 s37, s37, s38
    s_add_u32 s37, s37, 0x40000
    v_and_b32 v33, 1, v0
    v_bfe_u32 v32, v0, 1, 1
    v_lshlrev_b32 v33, 7, v33
    v_lshl_add_u32 v33, v32, 13, v33
    s_mul_i32 s38, s32, 240
    s_sub_u32 s38, 0x4000, s38
    v_cmp_lt_u32 vcc, 3, v0
    v_mov_b32 v32, s38
    s_nop 0
    v_cndmask_b32 v33, v33, v32, vcc
    v_add_u32 v33, s37, v33
    global_load_dword v119, v33, s[26:27] sc1
    s_mov_b32 s38, 0xffff0000
    s_waitcnt vmcnt(33)
    v_lshlrev_b32 v12, 16, v8
    v_and_b32 v13, s38, v8
    v_lshlrev_b32 v14, 16, v9
    v_and_b32 v15, s38, v9
    v_lshlrev_b32 v16, 16, v10
    v_and_b32 v17, s38, v10
    v_lshlrev_b32 v18, 16, v11
    v_and_b32 v19, s38, v11
    v_pk_add_f32 v[22:23], v[12:13], v[14:15]
    v_pk_add_f32 v[24:25], v[16:17], v[18:19]
    v_pk_add_f32 v[22:23], v[22:23], v[24:25]
    v_add_f32 v22, v22, v23
    v_lshrrev_b32 v126, 4, v0
    v_bfe_u32 v4, v0, 2, 2
    v_add_f32_dpp v22, v22, v22 row_ror:1 row_mask:0xf bank_mask:0xf
    v_lshl_add_u32 v5, v126, 3, v4
    v_and_b32 v6, 3, v0
    v_add_f32_dpp v22, v22, v22 row_ror:2 row_mask:0xf bank_mask:0xf
    v_lshlrev_b32 v7, 3, v6
    v_lshl_add_u32 v5, v5, 7, v7
    v_add_f32_dpp v22, v22, v22 row_ror:4 row_mask:0xf bank_mask:0xf
    v_bfe_u32 v4, v0, 3, 2
    v_xor_b32 v7, 0, v4
    v_add_f32_dpp v22, v22, v22 row_ror:8 row_mask:0xf bank_mask:0xf
    v_mov_b32 v23, v22
    v_lshl_add_u32 v120, v7, 5, v5
    v_xor_b32 v7, 1, v4
    v_permlane16_swap_b32 v23, v22
    v_add_f32 v22, v22, v23
    v_mov_b32 v23, v22
    v_lshl_add_u32 v121, v7, 5, v5
    v_xor_b32 v7, 2, v4
    v_permlane32_swap_b32 v23, v22
    v_add_f32_e64 v22, v22, v23
    v_mul_f32 v22, 0x3b000000, v22
    v_pk_add_f32 v[24:25], v[12:13], v[22:23] op_sel_hi:[1,0] neg_lo:[0,1] neg_hi:[0,1]
    v_pk_add_f32 v[26:27], v[14:15], v[22:23] op_sel_hi:[1,0] neg_lo:[0,1] neg_hi:[0,1]
    v_pk_add_f32 v[28:29], v[16:17], v[22:23] op_sel_hi:[1,0] neg_lo:[0,1] neg_hi:[0,1]
    v_pk_add_f32 v[30:31], v[18:19], v[22:23] op_sel_hi:[1,0] neg_lo:[0,1] neg_hi:[0,1]
    v_cvt_pk_bf16_f32 v22, 0, v22
    v_pk_mul_f32 v[32:33], v[24:25], v[24:25]
    v_pk_fma_f32 v[32:33], v[26:27], v[26:27], v[32:33]
    v_pk_fma_f32 v[32:33], v[28:29], v[28:29], v[32:33]
    v_pk_fma_f32 v[32:33], v[30:31], v[30:31], v[32:33]
    v_add_f32_e64 v32, v32, v33
    v_pk_add_f32 v[12:13], v[12:13], v[22:23] op_sel_hi:[1,0] neg_lo:[0,1] neg_hi:[0,1]
    v_pk_add_f32 v[14:15], v[14:15], v[22:23] op_sel_hi:[1,0] neg_lo:[0,1] neg_hi:[0,1]
    v_add_f32_dpp v32, v32, v32 row_ror:1 row_mask:0xf bank_mask:0xf
    v_pk_add_f32 v[16:17], v[16:17], v[22:23] op_sel_hi:[1,0] neg_lo:[0,1] neg_hi:[0,1]
    v_pk_add_f32 v[18:19], v[18:19], v[22:23] op_sel_hi:[1,0] neg_lo:[0,1] neg_hi:[0,1]
    v_add_f32_dpp v32, v32, v32 row_ror:2 row_mask:0xf bank_mask:0xf
    v_cvt_pk_bf16_f32 v12, 0, v12
    v_cvt_pk_bf16_f32 v13, 0, v13
    v_add_f32_dpp v32, v32, v32 row_ror:4 row_mask:0xf bank_mask:0xf
    v_cvt_pk_bf16_f32 v14, 0, v14
    v_cvt_pk_bf16_f32 v15, 0, v15
    v_add_f32_dpp v32, v32, v32 row_ror:8 row_mask:0xf bank_mask:0xf
    v_mov_b32 v33, v32
    v_cvt_pk_bf16_f32 v16, 0, v16
    v_cvt_pk_bf16_f32 v17, 0, v17
    v_permlane16_swap_b32 v33, v32
    v_add_f32 v32, v32, v33
    v_mov_b32 v33, v32
    v_cvt_pk_bf16_f32 v18, 0, v18
    v_cvt_pk_bf16_f32 v19, 0, v19
    v_permlane32_swap_b32 v33, v32
    v_add_f32 v32, v32, v33
    v_mul_f32 v32, 0x3b000000, v32
    v_cvt_pk_bf16_f32 v32, 0, v32
    v_add_f32 v32, 0x3727c5ac, v32
    v_cvt_pk_bf16_f32 v32, 0, v32
    v_sqrt_f32 v32, v32
    v_lshl_add_u32 v122, v7, 5, v5
    v_cvt_pk_bf16_f32 v32, 0, v32
    v_rcp_f32 v32, v32
    v_xor_b32_e64 v7, 3, v4
    v_pk_mul_f32 v[12:13], v[12:13], v[32:33] op_sel_hi:[1,0]
    v_pk_mul_f32 v[14:15], v[14:15], v[32:33] op_sel_hi:[1,0]
    v_pk_mul_f32 v[16:17], v[16:17], v[32:33] op_sel_hi:[1,0]
    v_pk_mul_f32 v[18:19], v[18:19], v[32:33] op_sel_hi:[1,0]
    v_cvt_pk_bf16_f32 v8, v12, v13
    v_cvt_pk_bf16_f32 v9, v14, v15
    v_cvt_pk_bf16_f32 v10, v16, v17
    v_cvt_pk_bf16_f32 v11, v18, v19
    ds_write_b128 v3, v[8:11] offset:32768
    v_lshl_add_u32 v123, v7, 5, v5
    s_lshl_b32 s37, s50, 8
    v_lshl_add_u32 v34, v126, 4, s37
    s_lshl_b32 s53, s31, 15
    s_add_u32 s53, s53, 0x40000
    s_lshl_b32 s39, s55, 2
    s_add_u32 s55, s39, s50
    s_lshl_b32 s39, s55, 8
    s_add_u32 s39, s39, s53
    v_lshrrev_b32 v4, 2, v0
    v_lshl_add_u32 v35, v4, 4, s39
    s_waitcnt lgkmcnt(0)
    ds_read_b128 v[40:43], v34 offset:32768
    ds_read_b128 v[44:47], v34 offset:32832
    ds_read_b128 v[48:51], v34 offset:32896
    ds_read_b128 v[52:55], v34 offset:32960
    s_add_u32 s33, s33, 0x9e3779b9
    v_lshlrev_b32 v4, 2, v6
    v_lshrrev_b32 v124, v4, s33
    v_and_b32 v124, 15, v124
    v_lshlrev_b32 v4, 3, v6
    v_lshrrev_b32 v125, v4, s33
    v_and_b32 v125, 0xff, v125
    s_mov_b32 s44, 0
    s_mov_b32 s45, -1
    s_waitcnt vmcnt(29)
    ds_read_b64_tr_b16 v[56:57], v120 offset:0
    ds_read_b64_tr_b16 v[58:59], v120 offset:512
    ds_read_b64_tr_b16 v[60:61], v121 offset:0
    ds_read_b64_tr_b16 v[62:63], v121 offset:512
    ds_read_b64_tr_b16 v[64:65], v122 offset:0
    ds_read_b64_tr_b16 v[66:67], v122 offset:512
    ds_read_b64_tr_b16 v[68:69], v123 offset:0
    ds_read_b64_tr_b16 v[70:71], v123 offset:512
    s_waitcnt vmcnt(25)
    s_waitcnt lgkmcnt(6)
    v_mfma_f32_16x16x32_bf16 v[88:91], v[40:43], v[56:59], 0
    ds_read_b64_tr_b16 v[72:73], v120 offset:4096
    ds_read_b64_tr_b16 v[74:75], v120 offset:4608
    s_waitcnt lgkmcnt(6)
    v_mfma_f32_16x16x32_bf16 v[92:95], v[40:43], v[60:63], 0
    ds_read_b64_tr_b16 v[76:77], v121 offset:4096
    ds_read_b64_tr_b16 v[78:79], v121 offset:4608
    s_waitcnt lgkmcnt(6)
    v_mfma_f32_16x16x32_bf16 v[96:99], v[40:43], v[64:67], 0
    ds_read_b64_tr_b16 v[80:81], v122 offset:4096
    ds_read_b64_tr_b16 v[82:83], v122 offset:4608
    s_waitcnt lgkmcnt(6)
    v_mfma_f32_16x16x32_bf16 v[100:103], v[40:43], v[68:71], 0
    ds_read_b64_tr_b16 v[84:85], v123 offset:4096
    ds_read_b64_tr_b16 v[86:87], v123 offset:4608
    s_waitcnt vmcnt(21)
    s_waitcnt lgkmcnt(6)
    v_mfma_f32_16x16x32_bf16 v[88:91], v[44:47], v[72:75], v[88:91]
    ds_read_b64_tr_b16 v[56:57], v120 offset:8192
    ds_read_b64_tr_b16 v[58:59], v120 offset:8704
    s_waitcnt lgkmcnt(6)
    v_mfma_f32_16x16x32_bf16 v[92:95], v[44:47], v[76:79], v[92:95]
    ds_read_b64_tr_b16 v[60:61], v121 offset:8192
    ds_read_b64_tr_b16 v[62:63], v121 offset:8704
    s_waitcnt lgkmcnt(6)
    v_mfma_f32_16x16x32_bf16 v[96:99], v[44:47], v[80:83], v[96:99]
    ds_read_b64_tr_b16 v[64:65], v122 offset:8192
    ds_read_b64_tr_b16 v[66:67], v122 offset:8704
    s_waitcnt lgkmcnt(6)
    v_mfma_f32_16x16x32_bf16 v[100:103], v[44:47], v[84:87], v[100:103]
    ds_read_b64_tr_b16 v[68:69], v123 offset:8192
    ds_read_b64_tr_b16 v[70:71], v123 offset:8704
    s_waitcnt vmcnt(17)
    s_waitcnt lgkmcnt(6)
    v_mfma_f32_16x16x32_bf16 v[88:91], v[48:51], v[56:59], v[88:91]
    ds_read_b64_tr_b16 v[72:73], v120 offset:12288
    ds_read_b64_tr_b16 v[74:75], v120 offset:12800
    s_waitcnt lgkmcnt(6)
    v_mfma_f32_16x16x32_bf16 v[92:95], v[48:51], v[60:63], v[92:95]
    ds_read_b64_tr_b16 v[76:77], v121 offset:12288
    ds_read_b64_tr_b16 v[78:79], v121 offset:12800
    s_waitcnt lgkmcnt(6)
    v_mfma_f32_16x16x32_bf16 v[96:99], v[48:51], v[64:67], v[96:99]
    ds_read_b64_tr_b16 v[80:81], v122 offset:12288
    ds_read_b64_tr_b16 v[82:83], v122 offset:12800
    s_waitcnt lgkmcnt(6)
    v_mfma_f32_16x16x32_bf16 v[100:103], v[48:51], v[68:71], v[100:103]
    ds_read_b64_tr_b16 v[84:85], v123 offset:12288
    ds_read_b64_tr_b16 v[86:87], v123 offset:12800
    s_waitcnt lgkmcnt(6)
    v_mfma_f32_16x16x32_bf16 v[88:91], v[52:55], v[72:75], v[88:91]
    s_waitcnt lgkmcnt(4)
    v_mfma_f32_16x16x32_bf16 v[92:95], v[52:55], v[76:79], v[92:95]
    s_waitcnt lgkmcnt(2)
    v_mfma_f32_16x16x32_bf16 v[96:99], v[52:55], v[80:83], v[96:99]
    s_waitcnt lgkmcnt(0)
    v_mfma_f32_16x16x32_bf16 v[100:103], v[52:55], v[84:87], v[100:103]
    s_barrier
    s_mov_b32 vcc_lo, 0xffff0000
    s_mov_b32 vcc_hi, 0xffff0000
    s_movk_i32 s37, 0xfff0
    s_nop 2
    v_cndmask_b32 v24, v88, v92, vcc
    s_nop 0
    v_cndmask_b32 v25, v96, v100, vcc
    v_cndmask_b32 v24, v24, v25, s[44:45]
    v_and_or_b32 v24, v24, s37, v124
    s_nop 1
    v_mov_b32_dpp v25, v24 quad_perm:[1,1,1,1] row_mask:0xf bank_mask:0xf
    v_mov_b32_dpp v26, v24 quad_perm:[2,2,2,2] row_mask:0xf bank_mask:0xf
    v_mov_b32_dpp v27, v24 quad_perm:[3,3,3,3] row_mask:0xf bank_mask:0xf
    s_mov_b32 exec_lo, 0x11111111
    s_mov_b32 exec_hi, 0x11111111
    global_store_dwordx4 v35, v[24:27], s[26:27]
    s_mov_b64 exec, -1
    v_mov_b32 v4, 0
    ds_read_b128 v[112:115], v4 offset:34864
    s_getreg_b32 s34, hwreg(HW_REG_XCC_ID, 0, 4)
    s_and_b32 s37, s33, 0xff
    s_lshl_b32 s39, s34, 8
    s_or_b32 s54, s37, s39
    v_mov_b32 v28, s54
    s_bfe_u32 s37, s33, 0x80008
    v_mov_b32 v29, s37
    s_bfe_u32 s37, s33, 0x80010
    v_mov_b32 v30, s37
    s_bfe_u32 s37, s33, 0x80018
    v_mov_b32 v31, s37
    s_waitcnt lgkmcnt(0)
    v_add3_u32 v112, v112, v113, v114
    v_add_u32 v112, v112, v115
    v_lshl_add_u32 v29, v112, 8, v29
    s_lshl_b32 s39, s32, 4
    s_add_u32 s39, s39, s53
    s_add_u32 s39, s39, 0x4000
    v_mov_b32 v22, s39
    v_add_u32 v109, 0x40000, v22
    s_mov_b64 exec, 1
    global_store_dwordx4 v22, v[28:31], s[26:27]
    s_mov_b64 exec, -1
    s_sub_i32 s39, s32, s55
    s_lshl_b32 s39, s39, 8
    s_add_u32 s39, s39, 0x2000
    v_add_u32 v108, s39, v35
    s_cmp_ge_u32 s51, 4
    s_cbranch_scc1 L_noff2
    s_waitcnt vmcnt(15)
    ds_read_b64_tr_b16 v[56:57], v120 offset:16384
    ds_read_b64_tr_b16 v[58:59], v120 offset:16896
    ds_read_b64_tr_b16 v[60:61], v121 offset:16384
    ds_read_b64_tr_b16 v[62:63], v121 offset:16896
    ds_read_b64_tr_b16 v[64:65], v122 offset:16384
    ds_read_b64_tr_b16 v[66:67], v122 offset:16896
    ds_read_b64_tr_b16 v[68:69], v123 offset:16384
    ds_read_b64_tr_b16 v[70:71], v123 offset:16896
    s_waitcnt vmcnt(11)
    s_waitcnt lgkmcnt(6)
    v_mfma_f32_16x16x32_bf16 v[88:91], v[40:43], v[56:59], 0
    ds_read_b64_tr_b16 v[72:73], v120 offset:20480
    ds_read_b64_tr_b16 v[74:75], v120 offset:20992
    s_waitcnt lgkmcnt(6)
    v_mfma_f32_16x16x32_bf16 v[92:95], v[40:43], v[60:63], 0
    ds_read_b64_tr_b16 v[76:77], v121 offset:20480
    ds_read_b64_tr_b16 v[78:79], v121 offset:20992
    s_waitcnt lgkmcnt(6)
    v_mfma_f32_16x16x32_bf16 v[96:99], v[40:43], v[64:67], 0
    ds_read_b64_tr_b16 v[80:81], v122 offset:20480
    ds_read_b64_tr_b16 v[82:83], v122 offset:20992
    s_waitcnt lgkmcnt(6)
    v_mfma_f32_16x16x32_bf16 v[100:103], v[40:43], v[68:71], 0
    ds_read_b64_tr_b16 v[84:85], v123 offset:20480
    ds_read_b64_tr_b16 v[86:87], v123 offset:20992
    s_waitcnt vmcnt(7)
    s_waitcnt lgkmcnt(6)
    v_mfma_f32_16x16x32_bf16 v[88:91], v[44:47], v[72:75], v[88:91]
    ds_read_b64_tr_b16 v[56:57], v120 offset:24576
    ds_read_b64_tr_b16 v[58:59], v120 offset:25088
    s_waitcnt lgkmcnt(6)
    v_mfma_f32_16x16x32_bf16 v[92:95], v[44:47], v[76:79], v[92:95]
    ds_read_b64_tr_b16 v[60:61], v121 offset:24576
    ds_read_b64_tr_b16 v[62:63], v121 offset:25088
    s_waitcnt lgkmcnt(6)
    v_mfma_f32_16x16x32_bf16 v[96:99], v[44:47], v[80:83], v[96:99]
    ds_read_b64_tr_b16 v[64:65], v122 offset:24576
    ds_read_b64_tr_b16 v[66:67], v122 offset:25088
    s_waitcnt lgkmcnt(6)
    v_mfma_f32_16x16x32_bf16 v[100:103], v[44:47], v[84:87], v[100:103]
    ds_read_b64_tr_b16 v[68:69], v123 offset:24576
    ds_read_b64_tr_b16 v[70:71], v123 offset:25088
    s_waitcnt vmcnt(3)
    s_waitcnt lgkmcnt(6)
    v_mfma_f32_16x16x32_bf16 v[88:91], v[48:51], v[56:59], v[88:91]
    ds_read_b64_tr_b16 v[72:73], v120 offset:28672
    ds_read_b64_tr_b16 v[74:75], v120 offset:29184
    s_waitcnt lgkmcnt(6)
    v_mfma_f32_16x16x32_bf16 v[92:95], v[48:51], v[60:63], v[92:95]
    ds_read_b64_tr_b16 v[76:77], v121 offset:28672
    ds_read_b64_tr_b16 v[78:79], v121 offset:29184
    s_waitcnt lgkmcnt(6)
    v_mfma_f32_16x16x32_bf16 v[96:99], v[48:51], v[64:67], v[96:99]
    ds_read_b64_tr_b16 v[80:81], v122 offset:28672
    ds_read_b64_tr_b16 v[82:83], v122 offset:29184
    s_waitcnt lgkmcnt(6)
    v_mfma_f32_16x16x32_bf16 v[100:103], v[48:51], v[68:71], v[100:103]
    ds_read_b64_tr_b16 v[84:85], v123 offset:28672
    ds_read_b64_tr_b16 v[86:87], v123 offset:29184
    s_waitcnt lgkmcnt(6)
    v_mfma_f32_16x16x32_bf16 v[88:91], v[52:55], v[72:75], v[88:91]
    s_waitcnt lgkmcnt(4)
    v_mfma_f32_16x16x32_bf16 v[92:95], v[52:55], v[76:79], v[92:95]
    s_waitcnt lgkmcnt(2)
    v_mfma_f32_16x16x32_bf16 v[96:99], v[52:55], v[80:83], v[96:99]
    s_waitcnt lgkmcnt(0)
    v_mfma_f32_16x16x32_bf16 v[100:103], v[52:55], v[84:87], v[100:103]
    s_mov_b32 vcc_lo, 0xffff0000
    s_mov_b32 vcc_hi, 0xffff0000
    s_movk_i32 s37, 0xff00
    s_nop 2
    v_cndmask_b32 v104, v88, v92, vcc
    s_nop 0
    v_cndmask_b32 v105, v96, v100, vcc
    v_cndmask_b32 v104, v104, v105, s[44:45]
    v_and_or_b32 v104, v104, s37, v125
    s_nop 0
    s_nop 0
    v_mov_b32_dpp v105, v104 quad_perm:[1,1,1,1] row_mask:0xf bank_mask:0xf
    v_mov_b32_dpp v106, v104 quad_perm:[2,2,2,2] row_mask:0xf bank_mask:0xf
    v_mov_b32_dpp v107, v104 quad_perm:[3,3,3,3] row_mask:0xf bank_mask:0xf
    s_mov_b32 exec_lo, 0x11111111
    s_mov_b32 exec_hi, 0x11111111
    global_store_dwordx4 v108, v[104:107], s[26:27]
    s_mov_b64 exec, -1
L_noff2:
    v_and_b32 v4, 15, v0
    v_lshlrev_b32 v4, 4, v4
    v_lshl_add_u32 v4, v126, 10, v4
    s_add_u32 s37, s53, 2432
    v_add_u32 v36, s37, v4
    v_and_b32 v4, 31, v0
    s_add_u32 s37, s53, 0x4000
    v_lshl_add_u32 v37, v4, 4, s37
    s_lshl_b32 s39, s40, 1
    s_sub_u32 s52, 8, s39
    s_mul_i32 s39, s52, s32
    s_sub_u32 s37, s52, 1
    v_and_b32 v4, 7, v0
    v_min_u32 v4, s37, v4
    v_add_u32 v39, s39, v4
    v_lshrrev_b32_e64 v4, 6, v39
    v_bfe_u32 v5, v0, 3, 1
    v_lshl_add_u32 v4, v4, 1, v5
    v_lshl_add_u32 v4, v4, 2, v126
    v_bfe_u32 v5, v39, 2, 4
    v_lshlrev_b32 v5, 4, v5
    v_lshl_add_u32 v4, v4, 8, v5
    s_add_u32 s37, s53, 0x2000
    v_add_u32 v38, s37, v4
    s_bfe_u32 s56, s33, 0x40000
    s_bfe_u32 s57, s33, 0x40004
    s_bfe_u32 s58, s33, 0x40008
    s_bfe_u32 s59, s33, 0x4000c
    s_movk_i32 s62, 255
    s_mov_b32 s60, 0x0c0c0400
    s_mov_b32 s61, 0x04000c0c
    s_mov_b32 s35, 0
L_poll1:
    global_load_dwordx4 v[40:43], v36, s[26:27] offset:-2432 sc1
    global_load_dwordx4 v[44:47], v36, s[26:27] offset:-2176 sc1
    global_load_dwordx4 v[48:51], v36, s[26:27] offset:-1920 sc1
    global_load_dwordx4 v[52:55], v36, s[26:27] offset:-1664 sc1
    global_load_dwordx4 v[56:59], v36, s[26:27] offset:1664 sc1
    global_load_dwordx4 v[60:63], v36, s[26:27] offset:1920 sc1
    global_load_dwordx4 v[64:67], v36, s[26:27] offset:2176 sc1
    global_load_dwordx4 v[68:71], v36, s[26:27] offset:2432 sc1
    global_load_dwordx4 v[72:75], v37, s[26:27] sc1
    global_load_dwordx4 v[76:79], v38, s[26:27] sc1
    s_add_u32 s35, s35, 1
    s_cmp_ge_u32 s35, 24
    s_cselect_b32 s37, 0xc0000, 0
    v_xor_b32 v36, s37, v36
    v_xor_b32 v37, s37, v37
    v_xor_b32 v38, s37, v38
    s_cmp_gt_u32 s35, 200000
    s_cbranch_scc1 L_end
    s_waitcnt vmcnt(9)
    v_xor_b32 v40, s56, v40
    v_xor_b32 v41, s57, v41
    v_xor_b32 v42, s58, v42
    v_xor_b32 v43, s59, v43
    v_or3_b32 v21, v40, v41, v42
    v_or_b32 v21, v21, v43
    s_waitcnt vmcnt(8)
    v_xor_b32 v44, s56, v44
    v_xor_b32 v45, s57, v45
    v_xor_b32 v46, s58, v46
    v_xor_b32 v47, s59, v47
    v_or3_b32 v21, v21, v44, v45
    v_or3_b32 v21, v21, v46, v47
    s_waitcnt vmcnt(7)
    v_xor_b32 v48, s56, v48
    v_xor_b32 v49, s57, v49
    v_xor_b32 v50, s58, v50
    v_xor_b32 v51, s59, v51
    v_or3_b32 v21, v21, v48, v49
    v_or3_b32 v21, v21, v50, v51
    s_waitcnt vmcnt(6)
    v_xor_b32 v52, s56, v52
    v_xor_b32 v53, s57, v53
    v_xor_b32 v54, s58, v54
    v_xor_b32 v55, s59, v55
    v_or3_b32 v21, v21, v52, v53
    v_or3_b32 v21, v21, v54, v55
    s_waitcnt vmcnt(5)
    v_xor_b32 v56, s56, v56
    v_xor_b32 v57, s57, v57
    v_xor_b32 v58, s58, v58
    v_xor_b32 v59, s59, v59
    v_or3_b32 v21, v21, v56, v57
    v_or3_b32 v21, v21, v58, v59
    s_waitcnt vmcnt(4)
    v_xor_b32 v60, s56, v60
    v_xor_b32 v61, s57, v61
    v_xor_b32 v62, s58, v62
    v_xor_b32 v63, s59, v63
    v_or3_b32 v21, v21, v60, v61
    v_or3_b32 v21, v21, v62, v63
    s_waitcnt vmcnt(3)
    v_xor_b32 v64, s56, v64
    v_xor_b32 v65, s57, v65
    v_xor_b32 v66, s58, v66
    v_xor_b32 v67, s59, v67
    v_or3_b32 v21, v21, v64, v65
    v_or3_b32 v21, v21, v66, v67
    s_waitcnt vmcnt(2)
    v_xor_b32 v68, s56, v68
    v_xor_b32 v69, s57, v69
    v_xor_b32 v70, s58, v70
    v_xor_b32 v71, s59, v71
    v_or3_b32 v21, v21, v68, v69
    v_or3_b32 v21, v21, v70, v71
    v_and_b32 v21, 15, v21
    s_waitcnt vmcnt(1)
    v_perm_b32 v22, v73, v72, s60
    v_perm_b32 v23, v75, v74, s61
    v_or_b32 v22, v22, v23
    v_cmp_ne_u32 vcc, s33, v22
    v_cmp_ne_u32 s[46:47], 0, v21
    s_or_b64 vcc, vcc, s[46:47]
    s_cbranch_vccz L_got1
    s_cmp_lg_u32 s35, 4
    s_cbranch_scc1 L_poll1
    v_add_u32 v22, 0x40000, v35
    v_add_u32 v23, 0x40000, v108
    s_mov_b64 exec, 1
    global_store_dwordx4 v109, v[28:31], s[26:27] sc1
    s_mov_b32 exec_lo, 0x11111111
    s_mov_b32 exec_hi, 0x11111111
    global_store_dwordx4 v22, v[24:27], s[26:27] sc1
    s_cmp_ge_u32 s51, 4
    s_cbranch_scc1 L_pb_a
    global_store_dwordx4 v23, v[104:107], s[26:27] sc1
L_pb_a:
    s_mov_b64 exec, -1
    s_branch L_poll1
L_got1:
    v_add_f32 v40, v40, v44
    v_add_f32 v48, v48, v52
    v_add_f32 v41, v41, v45
    v_add_f32 v49, v49, v53
    v_add_f32 v42, v42, v46
    v_add_f32 v50, v50, v54
    v_add_f32 v43, v43, v47
    v_add_f32 v51, v51, v55
    v_add_f32 v40, v40, v48
    v_add_f32 v41, v41, v49
    v_add_f32 v42, v42, v50
    v_add_f32 v43, v43, v51
    v_cvt_pk_bf16_f32 v40, v40, v41
    v_cvt_pk_bf16_f32 v41, v42, v43
    v_add_f32 v56, v56, v60
    v_add_f32 v64, v64, v68
    v_add_f32 v57, v57, v61
    v_add_f32 v65, v65, v69
    v_add_f32 v58, v58, v62
    v_add_f32 v66, v66, v70
    v_add_f32 v59, v59, v63
    v_add_f32 v67, v67, v71
    v_add_f32 v56, v56, v64
    v_add_f32 v57, v57, v65
    v_add_f32 v58, v58, v66
    v_add_f32 v59, v59, v67
    v_cvt_pk_bf16_f32 v56, v56, v57
    v_cvt_pk_bf16_f32 v57, v58, v59
    v_lshlrev_b32 v22, 3, v0
    ds_write_b64 v22, v[40:41] offset:33792
    ds_write_b64 v22, v[56:57] offset:34304
    v_cmp_ne_u32 vcc, s54, v72
    s_cmp_eq_u64 vcc, 0
    s_cselect_b32 s36, 1, 0
    v_mov_b32 v26, s36
    v_mov_b32 v27, s33
    v_mov_b32 v22, 34848
    ds_write_b64 v22, v[26:27]
    s_waitcnt vmcnt(0)
    v_perm_b32 v22, v77, v76, s60
    v_perm_b32 v23, v79, v78, s61
    v_or_b32 v22, v22, v23
    v_cmp_ne_u32 vcc, s33, v22
    s_cbranch_vccz L_aux_b1
    global_load_dwordx4 v[76:79], v38, s[26:27] sc1
L_aux_b1:
    s_waitcnt lgkmcnt(0)
    s_barrier
    s_cmp_gt_u32 s35, 4
    s_cbranch_scc1 L_b_done
    s_bitcmp1_b32 s36, 0
    s_cbranch_scc1 L_b_done
    v_add_u32 v22, 0x40000, v35
    v_add_u32 v23, 0x40000, v108
    s_mov_b64 exec, 1
    global_store_dwordx4 v109, v[28:31], s[26:27] sc1
    s_mov_b32 exec_lo, 0x11111111
    s_mov_b32 exec_hi, 0x11111111
    global_store_dwordx4 v22, v[24:27], s[26:27] sc1
    s_cmp_ge_u32 s51, 4
    s_cbranch_scc1 L_pb_b
    global_store_dwordx4 v23, v[104:107], s[26:27] sc1
L_pb_b:
    s_mov_b64 exec, -1
L_b_done:
    v_cmp_gt_i32 vcc, 0, v73
    v_cmp_lt_i32 s[46:47], s62, v73
    s_bcnt1_i32_b32 s37, vcc_lo
    s_bcnt1_i32_b32 s39, s46
    s_cmp_gt_u32 s37, s39
    s_cselect_b32 s55, 0x2000, 0
    s_branch L_chk_aux
L_poll_aux:
    global_load_dwordx4 v[76:79], v38, s[26:27] sc1
    s_add_u32 s35, s35, 1
    s_cmp_ge_u32 s35, 24
    s_cselect_b32 s37, 0xc0000, 0
    v_xor_b32 v38, s37, v38
    s_cmp_gt_u32 s35, 200000
    s_cbranch_scc1 L_end
L_chk_aux:
    s_waitcnt vmcnt(0)
    v_perm_b32 v22, v77, v76, s60
    v_perm_b32 v23, v79, v78, s61
    v_or_b32 v22, v22, v23
    v_cmp_ne_u32 vcc, s33, v22
    s_cbranch_vccnz L_poll_aux
    s_movk_i32 s37, 0xff00
    v_and_b32 v23, 1, v39
    v_cmp_eq_u32 vcc, 0, v23
    v_and_b32 v23, 2, v39
    v_cmp_eq_u32 s[46:47], 0, v23
    v_cndmask_b32 v24, v77, v76, vcc
    v_cndmask_b32 v25, v79, v78, vcc
    v_cndmask_b32 v24, v25, v24, s[46:47]
    v_and_b32 v24, s37, v24
    v_mov_b32 v23, v24
    s_nop 1
    v_permlane16_swap_b32 v23, v24
    v_add_f32 v24, v24, v23
    v_mov_b32 v23, v24
    s_nop 1
    v_permlane32_swap_b32 v23, v24
    v_add_f32 v24, v24, v23
    v_cvt_pk_bf16_f32 v24, v24, v24
    v_and_b32 v24, s38, v24
    v_mul_f32 v25, 0xbfb8aa3b, v24
    v_exp_f32 v25, v25
    v_mov_b32_dpp v26, v24 row_ror:8 row_mask:0xf bank_mask:0xf
    v_add_f32 v25, 1.0, v25
    v_rcp_f32 v25, v25
    v_cmp_le_u32 vcc, s52, v0
    v_mul_f32 v25, v24, v25
    v_cvt_pk_bf16_f32 v25, v25, v25
    v_and_b32 v25, s38, v25
    v_mul_f32 v25, v25, v26
    v_cvt_pk_bf16_f32 v25, v25, v25
    v_cndmask_b32 v25, v25, 0, vcc
    v_lshlrev_b32 v22, 2, v0
    v_mov_b32 v26, s55
    v_mov_b32_e64 v27, 0
    ds_write_b32 v27, v26 offset:34856
    s_mov_b64 exec, 0xff
    ds_write_b32 v22, v25 offset:34816
    s_waitcnt lgkmcnt(0)
    s_endpgm
L_attn:
    s_lshl_b32 s37, s31, 24
    s_lshl_b32 s41, s32, 2
    s_add_u32 s41, s41, s30
    s_lshl_b32 s39, s41, 10
    s_add_u32 s37, s37, s39
    s_add_u32 s37, s37, 0xF00000
    v_and_b32 v120, 15, v0
    v_lshrrev_b32 v121, 4, v0
    v_lshlrev_b32 v122, 4, v120
    v_lshl_add_u32 v4, v0, 4, s37
    v_lshlrev_b32 v124, 6, v121
    v_xor_b32 v2, v124, v4
    s_lshl_b32 s38, s30, 13
    s_add_u32 m0, s38, 44032
    s_mov_b32 s42, 0x20000
    s_movk_i32 s43, 1024
    s_waitcnt lgkmcnt(2)
    s_and_b32 s39, s41, 15
    s_cbranch_scc1 L_touched
    s_load_dword s60, s[6:7], s37
    s_load_dword s61, s[8:9], s37
    s_lshl_b32 s39, s31, 19
    s_lshl_b32 s40, s32, 14
    s_add_u32 s39, s39, s40
    s_load_dword s62, s[12:13], s39
    s_mul_i32 s39, s2, 7168
    s_load_dword s63, s[20:21], s39
    s_load_dword s59, s[22:23], 0
L_touched:
    s_barrier
    global_load_lds_dwordx4 v2, s[6:7] nt
    s_add_u32 m0, m0, s43
    v_xor_b32 v2, 4112, v2
    v_add_u32 v2, s42, v2
    global_load_lds_dwordx4 v2, s[6:7] nt
    s_add_u32 m0, m0, s43
    v_xor_b32 v2, 12336, v2
    v_add_u32 v2, s42, v2
    global_load_lds_dwordx4 v2, s[6:7] nt
    s_add_u32 m0, m0, s43
    v_xor_b32 v2, 4112, v2
    v_add_u32 v2, s42, v2
    global_load_lds_dwordx4 v2, s[6:7] nt
    s_add_u32 m0, m0, s43
    v_xor_b32 v2, 28720, v2
    v_add_u32 v2, s42, v2
    global_load_lds_dwordx4 v2, s[6:7] nt
    s_add_u32 m0, m0, s43
    v_xor_b32 v2, 4112, v2
    v_add_u32 v2, s42, v2
    s_lshl_b32 s37, s31, 19
    s_lshl_b32 s39, s32, 14
    s_add_u32 s37, s37, s39
    s_lshl_b32 s40, s30, 8
    s_add_u32 s37, s37, s40
    s_add_u32 s37, s37, 0x1000
    v_lshl_add_u32 v8, v121, 10, v122
    v_add_u32 v6, s37, v8
    v_add_u32 v7, 0x2000, v6
    s_lshl_b32 s37, s31, 2
    s_lshr_b32 s39, 0x33221100, s37
    s_and_b32 s39, s39, 7
    s_sub_u32 s3, s37, s39
    s_lshr_b32 s39, 0x10101010, s37
    s_and_b32 s39, s39, 7
    s_lshl_b32 s37, s3, 6
    s_lshl_b32 s39, s39, 1
    s_sub_u32 s38, 8, s39
    s_mul_i32 s39, s38, s32
    s_add_u32 s37, s37, s39
    s_lshl_b32 s37, s37, 10
    s_add_u32 s37, s37, s40
    s_sub_u32 s38, s38, 1
    v_add_u32 v125, s37, v122
    v_min_u32 v8, s38, v121
    v_lshl_add_u32 v8, v8, 10, v125
    v_add_u32 v9, 4, v121
    v_min_u32 v9, s38, v9
    v_lshl_add_u32 v9, v9, 10, v125
    v_and_b32 v123, 1, v0
    v_and_b32 v124, 1, v121
    s_lshl_b32 s39, s32, 5
    v_bfe_u32 v125, v0, 3, 2
    v_lshl_add_u32 v10, v125, 3, s39
    v_lshrrev_b32_e64 v125, 5, v0
    v_lshl_add_u32 v10, v125, 2, v10
    s_mul_i32 s37, s31, 69632
    s_add_u32 s37, s37, 0x100000
    s_mul_i32 s38, s32, 2176
    s_add_u32 s38, s38, s37
    s_mul_i32 s39, s30, 17408
    s_lshl_b32 s40, s32, 6
    s_add_u32 s37, s37, s40
    s_add_u32 s39, s39, s37
    v_lshrrev_b32 v11, 3, v0
    v_mul_u32_u24 v11, 2176, v11
    v_bfe_u32 v125, v0, 1, 2
    v_lshlrev_b32 v125, 4, v125
    v_add3_u32 v11, v11, v125, s39
    v_lshl_add_u32 v12, v0, 4, s38
    s_lshl_b32 s40, s30, 4
    v_and_b32 v125, 31, v0
    v_lshrrev_b32 v14, 2, v0
    v_mul_u32_u24 v14, 2176, v14
    v_and_b32 v125, 3, v0
    v_lshlrev_b32 v125, 4, v125
    v_add3_u32 v14, v14, v125, s37
    v_add_u32 v164, 34816, v14
    s_lshl_b32 s40, s30, 9
    s_add_u32 s38, s38, s40
    v_lshl_add_u32 v13, v120, 5, s38
    v_lshl_add_u32 v13, v124, 4, v13
    s_lshr_b32 s37, s32, 1
    s_lshl_b32 s37, s37, 14
    s_and_b32 s40, s32, 1
    s_lshl_b32 s40, s40, 12
    s_add_u32 s37, s37, s40
    s_add_u32 s37, s37, 0x1c0000
    v_lshrrev_b32 v124, 3, v0
    v_lshl_add_u32 v124, v124, 4, s37
    v_and_b32 v15, 7, v0
    v_lshl_add_u32 v15, v15, 9, v124
    s_lshl_b32 s40, s31, 9
    s_add_u32 s37, s37, s40
    v_lshrrev_b32 v124, 5, v0
    v_lshl_add_u32 v124, v124, 6, v125
    v_bfe_u32 v125, v0, 2, 1
    v_lshlrev_b32 v125, 13, v125
    v_add3_u32 v150, v124, v125, s37
    s_and_b32 s40, s30, 1
    s_lshl_b32 s40, s40, 6
    s_add_u32 s3, s37, s40
    s_lshr_b32 s40, s30, 1
    s_lshl_b32 s40, s40, 13
    s_add_u32 s3, s3, s40
    v_lshlrev_b32 v125, 4, v123
    v_mov_b32 v124, 0xffff
    v_lshlrev_b32 v124, v125, v124
    v_and_b32 v125, 2, v0
    v_cmp_eq_u32 vcc, 0, v125
    v_lshrrev_b32 v125, 1, v120
    v_lshlrev_b32 v157, 2, v121
    v_mov_b32 v162, 0x0c0c0c0c
    v_mov_b32 v163, 0x01000100
    v_bfi_b32 v163, v124, v163, v162
    v_cndmask_b32 v160, v162, v163, vcc
    v_cndmask_b32 v161, v163, v162, vcc
    v_and_b32 v163, 0x02020202, v124
    v_cndmask_b32 v162, 0, v163, vcc
    v_cndmask_b32 v163, v163, 0, vcc
    v_add_u32 v162, v162, v160
    v_add_u32_e64 v163, v163, v161
    v_cmp_eq_u32 s[44:45], 0, v125
    v_cmp_eq_u32 s[46:47], 1, v125
    v_cmp_eq_u32 s[48:49], 2, v125
    v_cmp_eq_u32 s[50:51], 3, v125
    v_lshrrev_b32 v156, 2, v120
    v_lshlrev_b32 v125, 4, v121
    v_lshl_add_u32 v153, v156, 8, v125
    v_cndmask_b32 v146, 0, v124, s[44:45]
    v_cndmask_b32 v147, 0, v124, s[46:47]
    v_cndmask_b32 v148, 0, v124, s[48:49]
    v_cndmask_b32 v149, 0, v124, s[50:51]
    s_lshl_b32 s37, s30, 11
    v_lshl_add_u32 v154, v121, 9, v122
    v_add_u32 v154, s37, v154
    s_lshl_b32 s37, s30, 3
    v_lshl_add_u32 v156, v156, 5, s37
    v_bfe_u32 v124, v0, 1, 1
    v_lshrrev_b32 v125, 2, v0
    v_lshlrev_b32 v125, 4, v125
    v_lshl_add_u32 v125, v124, 8, v125
    v_lshl_add_u32 v125, v123, 3, v125
    s_lshl_b32 s37, s30, 9
    v_add_u32 v155, s37, v125
    v_and_b32 v124, 3, v0
    v_lshrrev_b32 v125, 2, v120
    v_lshlrev_b32 v125, 8, v125
    v_lshl_add_u32 v124, v124, 10, v125
    v_xor_b32 v125, v121, v120
    v_lshl_add_u32 v124, v125, 4, v124
    s_lshl_b32 s38, s30, 13
    v_add_u32 v140, s38, v124
    v_xor_b32 v141, 64, v140
    v_xor_b32 v142, 128, v140
    v_xor_b32 v143, 192, v140
    s_waitcnt vmcnt(4)
    global_load_lds_dwordx4 v2, s[6:7] nt
    s_add_u32 m0, m0, s43
    v_xor_b32 v2, 12336, v2
    v_add_u32 v2, s42, v2
    s_waitcnt vmcnt(4)
    global_load_lds_dwordx4 v2, s[6:7] nt
    s_add_u32 m0, m0, s43
    v_xor_b32 v2, 4112, v2
    v_add_u32 v2, s42, v2
    s_waitcnt vmcnt(4)
    global_load_lds_dwordx4 v2, s[6:7] nt
    s_lshl_b32 s37, s30, 9
    v_lshlrev_b32 v158, 3, v0
    v_sub_u32 v158, v12, v158
    v_add_u32 v158, s37, v158
    v_writelane_b32 v158, s3, 63
    global_load_dword v159, v158, s[26:27] sc1
    s_waitcnt vmcnt(5)
    global_load_dwordx4 v[48:51], v4, s[8:9] nt
    v_xor_b32 v4, 4096, v4
    v_add_u32 v4, s42, v4
    s_waitcnt vmcnt(5)
    global_load_dwordx4 v[52:55], v4, s[8:9] nt
    v_xor_b32 v4, 12288, v4
    v_add_u32 v4, s42, v4
    s_waitcnt vmcnt(5)
    global_load_dwordx4 v[56:59], v4, s[8:9] nt
    v_xor_b32 v4, 4096, v4
    v_add_u32 v4, s42, v4
    s_waitcnt vmcnt(5)
    global_load_dwordx4 v[60:63], v4, s[8:9] nt
    v_xor_b32 v4, 28672, v4
    v_add_u32 v4, s42, v4
    s_waitcnt vmcnt(5)
    global_load_dwordx4 v[64:67], v4, s[8:9] nt
    v_xor_b32 v4, 4096, v4
    v_add_u32 v4, s42, v4
    s_waitcnt vmcnt(5)
    global_load_dwordx4 v[68:71], v4, s[8:9] nt
    v_xor_b32 v4, 12288, v4
    v_add_u32 v4, s42, v4
    s_waitcnt vmcnt(5)
    global_load_dwordx4 v[72:75], v4, s[8:9] nt
    v_xor_b32 v4, 4096, v4
    v_add_u32 v4, s42, v4
    s_waitcnt vmcnt(7)
    ds_read_b128 v[16:19], v140 offset:44032
    ds_read_b128 v[20:23], v141 offset:44032
    ds_read_b128 v[24:27], v142 offset:44032
    ds_read_b128 v[28:31], v143 offset:44032
    ds_read_b128 v[32:35], v140 offset:48128
    ds_read_b128 v[36:39], v141 offset:48128
    ds_read_b128 v[40:43], v142 offset:48128
    ds_read_b128 v[44:47], v143 offset:48128
    s_waitcnt lgkmcnt(0)
    s_barrier
    ds_read_b128 v[104:107], v153 offset:33792
    ds_read_b128 v[108:111], v153 offset:33856
    ds_read_b128 v[112:115], v153 offset:33920
    ds_read_b128 v[116:119], v153 offset:33984
    global_load_dwordx4 v[76:79], v4, s[8:9] nt
    s_mov_b32 s46, 0x3db504f3
    s_mov_b32 s38, 0xffff0000
    s_mov_b32 s48, 0x3fb8aa3b
    s_waitcnt lgkmcnt(3)
    v_mfma_f32_16x16x32_bf16 v[120:123], v[16:19], v[104:107], 0
    v_mfma_f32_16x16x32_bf16 v[124:127], v[32:35], v[104:107], 0
    s_waitcnt lgkmcnt(2)
    v_mfma_f32_16x16x32_bf16 v[120:123], v[20:23], v[108:111], v[120:123]
    v_mfma_f32_16x16x32_bf16 v[124:127], v[36:39], v[108:111], v[124:127]
    s_waitcnt lgkmcnt(1)
    v_mfma_f32_16x16x32_bf16 v[120:123], v[24:27], v[112:115], v[120:123]
    v_mfma_f32_16x16x32_bf16 v[124:127], v[40:43], v[112:115], v[124:127]
    s_waitcnt lgkmcnt(0)
    v_mfma_f32_16x16x32_bf16 v[120:123], v[28:31], v[116:119], v[120:123]
    v_mfma_f32_16x16x32_bf16 v[124:127], v[44:47], v[116:119], v[124:127]
    v_mov_b32 v42, 34848
    s_lshl_b32 s40, s30, 5
    v_mov_b32 v47, s40
    ds_read_b64 v[42:43], v42
    s_nop 0
    s_nop 1
    v_cvt_pk_bf16_f32 v120, 0, v120
    v_cvt_pk_bf16_f32 v121, 0, v121
    v_cvt_pk_bf16_f32 v122, 0, v122
    v_cvt_pk_bf16_f32 v123, 0, v123
    v_cvt_pk_bf16_f32 v124, 0, v124
    v_cvt_pk_bf16_f32 v125, 0, v125
    v_cvt_pk_bf16_f32 v126, 0, v126
    v_cvt_pk_bf16_f32 v127, 0, v127
    v_pk_mul_f32 v[120:121], v[120:121], s[46:47] op_sel_hi:[1,0]
    v_pk_mul_f32 v[122:123], v[122:123], s[46:47] op_sel_hi:[1,0]
    v_pk_mul_f32 v[124:125], v[124:125], s[46:47] op_sel_hi:[1,0]
    v_pk_mul_f32 v[126:127], v[126:127], s[46:47] op_sel_hi:[1,0]
    v_cvt_pk_bf16_f32 v120, 0, v120
    v_cvt_pk_bf16_f32 v121, 0, v121
    v_cvt_pk_bf16_f32 v122, 0, v122
    v_cvt_pk_bf16_f32 v123, 0, v123
    v_cvt_pk_bf16_f32 v124, 0, v124
    v_cvt_pk_bf16_f32 v125, 0, v125
    v_cvt_pk_bf16_f32 v126, 0, v126
    v_cvt_pk_bf16_f32 v127, 0, v127
    v_max3_f32 v20, v120, v121, v122
    v_max3_f32 v22, v123, v124, v125
    v_max3_f32 v20, v20, v126, v127
    v_max_f32 v20, v20, v22
    v_mov_b32 v22, v20
    s_nop 1
    v_permlane16_swap_b32 v22, v20
    v_max_f32 v20, v20, v22
    v_mov_b32 v22, v20
    s_nop 1
    v_permlane32_swap_b32 v22, v20
    v_max_f32 v20, v20, v22
    v_mul_f32 v20, s48, v20
    v_pk_fma_f32 v[120:121], v[120:121], s[48:49], v[20:21] op_sel_hi:[1,0,0] neg_lo:[0,0,1] neg_hi:[0,0,1]
    v_pk_fma_f32 v[122:123], v[122:123], s[48:49], v[20:21] op_sel_hi:[1,0,0] neg_lo:[0,0,1] neg_hi:[0,0,1]
    v_pk_fma_f32 v[124:125], v[124:125], s[48:49], v[20:21] op_sel_hi:[1,0,0] neg_lo:[0,0,1] neg_hi:[0,0,1]
    v_pk_fma_f32 v[126:127], v[126:127], s[48:49], v[20:21] op_sel_hi:[1,0,0] neg_lo:[0,0,1] neg_hi:[0,0,1]
    v_exp_f32 v120, v120
    v_exp_f32 v121, v121
    v_exp_f32 v122, v122
    v_exp_f32 v123, v123
    v_exp_f32 v124, v124
    v_exp_f32 v125, v125
    v_exp_f32 v126, v126
    v_exp_f32 v127, v127
    v_cvt_pk_bf16_f32 v24, v120, v121
    v_cvt_pk_bf16_f32 v25, v122, v123
    v_cvt_pk_bf16_f32 v26, v124, v125
    v_cvt_pk_bf16_f32 v27, v126, v127
    v_perm_b32 v128, v24, v24, v160
    v_perm_b32 v129, v24, v24, v161
    v_perm_b32 v130, v24, v24, v162
    v_perm_b32 v131, v24, v24, v163
    v_perm_b32 v132, v25, v25, v160
    v_perm_b32 v133, v25, v25, v161
    v_perm_b32 v134, v25, v25, v162
    v_perm_b32 v135, v25, v25, v163
    v_perm_b32 v136, v26, v26, v160
    v_perm_b32 v137, v26, v26, v161
    v_perm_b32 v138, v26, v26, v162
    v_perm_b32 v139, v26, v26, v163
    v_perm_b32 v140, v27, v27, v160
    v_perm_b32 v141, v27, v27, v161
    v_perm_b32 v142, v27, v27, v162
    v_perm_b32 v143, v27, v27, v163
    v_pk_add_f32 v[120:121], v[120:121], v[122:123]
    v_pk_add_f32 v[124:125], v[124:125], v[126:127]
    v_pk_add_f32 v[120:121], v[120:121], v[124:125]
    v_add_f32 v21, v120, v121
    v_mov_b32 v22, v21
    s_nop 1
    v_permlane16_swap_b32 v22, v21
    v_add_f32 v21, v21, v22
    v_mov_b32 v22, v21
    s_nop 1
    v_permlane32_swap_b32 v22, v21
    v_add_f32 v21, v21, v22
    ds_write_b64 v156, v[20:21] offset:34880
    s_waitcnt lgkmcnt(0)
    v_readfirstlane_b32 s36, v42
    v_readfirstlane_b32 s33, v43
    s_waitcnt vmcnt(7)
    global_load_dword v1, v10, s[4:5]
    v_mfma_f32_16x16x16_bf16 v[104:107], v[128:129], v[48:49], 0
    v_mfma_f32_16x16x16_bf16 v[108:111], v[128:129], v[50:51], 0
    s_waitcnt vmcnt(7)
    global_load_dwordx4 v[96:99], v8, s[20:21] nt
    v_mfma_f32_16x16x16_bf16 v[104:107], v[130:131], v[52:53], v[104:107]
    v_mfma_f32_16x16x16_bf16 v[108:111], v[130:131], v[54:55], v[108:111]
    s_waitcnt vmcnt(7)
    global_load_dwordx4 v[100:103], v9, s[20:21] nt
    v_mfma_f32_16x16x16_bf16 v[104:107], v[132:133], v[56:57], v[104:107]
    v_mfma_f32_16x16x16_bf16 v[108:111], v[132:133], v[58:59], v[108:111]
    s_waitcnt vmcnt(7)
    global_load_dwordx4 v[80:83], v6, s[12:13] offset:-4096 nt
    v_mfma_f32_16x16x16_bf16 v[104:107], v[134:135], v[60:61], v[104:107]
    v_mfma_f32_16x16x16_bf16 v[108:111], v[134:135], v[62:63], v[108:111]
    s_waitcnt vmcnt(7)
    global_load_dwordx4 v[84:87], v6, s[12:13] offset:0 nt
    v_mfma_f32_16x16x16_bf16 v[104:107], v[136:137], v[64:65], v[104:107]
    v_mfma_f32_16x16x16_bf16 v[108:111], v[136:137], v[66:67], v[108:111]
    s_waitcnt vmcnt(7)
    global_load_dwordx4 v[88:91], v7, s[12:13] offset:-4096 nt
    v_mfma_f32_16x16x16_bf16 v[104:107], v[138:139], v[68:69], v[104:107]
    v_mfma_f32_16x16x16_bf16 v[108:111], v[138:139], v[70:71], v[108:111]
    s_waitcnt vmcnt(7)
    global_load_dwordx4 v[92:95], v7, s[12:13] offset:0 nt
    v_mfma_f32_16x16x16_bf16 v[104:107], v[140:141], v[72:73], v[104:107]
    v_mfma_f32_16x16x16_bf16 v[108:111], v[140:141], v[74:75], v[108:111]
    s_barrier
    ds_read_b128 v[16:19], v47 offset:34880
    ds_read_b128 v[20:23], v47 offset:34896
    ds_read_b32 v44, v157 offset:34816
    ds_read_b32 v45, v157 offset:34832
    v_mov_b32_e64 v46, 0
    ds_read_b32 v46, v46 offset:34856
    s_mov_b32 s54, 0x55555555
    s_mov_b32 s55, 0x55555555
    v_mov_b32 v123, s33
    s_waitcnt lgkmcnt(3)
    v_max3_f32 v124, v16, v18, v20
    v_max_f32 v124, v124, v22
    v_sub_f32 v16, v16, v124
    v_sub_f32 v18, v18, v124
    v_sub_f32 v20, v20, v124
    v_sub_f32 v22, v22, v124
    v_exp_f32 v16, v16
    v_exp_f32 v18, v18
    v_exp_f32 v20, v20
    v_exp_f32 v22, v22
    s_waitcnt lgkmcnt(0)
    v_mul_f32 v125, v16, v17
    v_fmac_f32 v125, v18, v19
    v_fmac_f32 v125, v20, v21
    v_fmac_f32 v125, v22, v23
    v_log_f32 v122, v125
    v_rcp_f32 v125, v125
    v_and_b32 v32, v44, v146
    v_and_b32 v33, v44, v147
    v_and_b32 v34, v44, v148
    v_and_b32 v35, v44, v149
    v_and_b32 v36, v45, v146
    v_and_b32 v37, v45, v147
    v_and_b32 v38, v45, v148
    v_and_b32 v39, v45, v149
    v_add_u32 v15, v46, v15
    v_add_f32 v122, v122, v124
    v_mul_f32 v16, v16, v125
    v_mul_f32 v18, v18, v125
    v_mul_f32 v20, v20, v125
    v_mul_f32 v22, v22, v125
    s_waitcnt vmcnt(7)
    v_mfma_f32_16x16x16_bf16 v[104:107], v[142:143], v[76:77], v[104:107]
    v_mfma_f32_16x16x16_bf16 v[108:111], v[142:143], v[78:79], v[108:111]
    s_nop 6
    ds_write_b128 v154, v[104:107] offset:35072
    ds_write_b128 v154, v[108:111] offset:35328
    s_waitcnt lgkmcnt(0)
    s_barrier
    ds_read_b64 v[24:25], v155 offset:35072
    ds_read_b64 v[26:27], v155 offset:37120
    ds_read_b64 v[28:29], v155 offset:39168
    ds_read_b64 v[30:31], v155 offset:41216
    s_bitcmp0_b32 s36, 0
    s_waitcnt lgkmcnt(3)
    v_mul_f32 v120, v16, v24
    v_mul_f32 v121, v16, v25
    s_waitcnt lgkmcnt(2)
    v_fmac_f32 v120, v18, v26
    v_fmac_f32 v121, v18, v27
    s_waitcnt lgkmcnt(1)
    v_fmac_f32 v120, v20, v28
    v_fmac_f32 v121, v20, v29
    s_waitcnt lgkmcnt(0)
    v_fmac_f32 v120, v22, v30
    v_fmac_f32 v121, v22, v31
    v_cvt_pk_bf16_f32 v120, v120, v121
    s_nop 1
    v_mov_b32_dpp v121, v120 quad_perm:[1,1,3,3] row_mask:0xf bank_mask:0xf
    s_mov_b64 exec, s[54:55]
    s_cbranch_scc1 L_slow_h2
    global_store_dwordx4 v11, v[120:123], s[26:27]
L_back_h2:
    s_mov_b64 exec, -1
    s_cmp_lg_u32 s30, 0
    s_cselect_b64 exec, 0, -1
    global_load_dwordx4 v[48:51], v12, s[26:27] offset:0 sc1
    global_load_dwordx4 v[52:55], v12, s[26:27] offset:1024 sc1
    s_mov_b64 exec, -1
    s_mov_b32 s35, 200000
    s_not_b32 s37, s33
    s_lshl_b32 s37, s37, 24
    s_and_b32 s62, s33, 0xffffff
    s_or_b32 s62, s62, s37
    v_mov_b32 v127, s62
    s_mov_b32 s56, 0x7060500
    s_bfe_u32 s60, s62, 0x80000
    s_mov_b32 s57, 0x7060501
    s_bfe_u32 s61, s62, 0x80008
    s_mov_b32 s58, 0x7060502
    s_bfe_u32 s52, s62, 0x80010
    s_mov_b32 s59, 0x7060503
    s_bfe_u32 s53, s62, 0x80018
    v_lshlrev_b32 v126, 2, v157
    v_and_b32 v125, 3, v0
    v_lshl_add_u32 v165, v125, 2, v126
    s_cmp_lg_u32 s30, 0
    s_cbranch_scc1 L_wait_a
    s_waitcnt vmcnt(2)
    global_load_dwordx4 v[56:59], v12, s[26:27] offset:0 sc1
    global_load_dwordx4 v[60:63], v12, s[26:27] offset:1024 sc1
    v_mfma_f32_16x16x32_bf16 v[112:115], v[32:35], v[96:99], 0
    v_mfma_f32_16x16x32_bf16 v[112:115], v[36:39], v[100:103], v[112:115]
L_poll2b:
    s_waitcnt vmcnt(3)
    v_cmp_ne_u32 vcc, s33, v51
    v_pk_mov_b32 v[16:17], v[48:49], v[48:49] op_sel:[0,1]
    v_mov_b32 v18, v50
    s_waitcnt vmcnt(2)
    v_cmp_ne_u32 s[44:45], s33, v55
    v_pk_mov_b32 v[20:21], v[52:53], v[52:53] op_sel:[0,1]
    v_mov_b32 v22, v54
    v_max_f32 v124, v50, v54
    s_or_b64 vcc, vcc, s[44:45]
    s_and_b64 exec, exec, vcc
    s_cbranch_scc0 L_got2b
    global_load_dwordx4 v[48:51], v12, s[26:27] offset:0 sc1
    global_load_dwordx4 v[52:55], v12, s[26:27] offset:1024 sc1
    s_waitcnt vmcnt(3)
    v_cmp_ne_u32 vcc, s33, v59
    v_pk_mov_b32 v[16:17], v[56:57], v[56:57] op_sel:[0,1]
    v_mov_b32 v18, v58
    s_waitcnt vmcnt(2)
    v_cmp_ne_u32 s[44:45], s33, v63
    v_pk_mov_b32 v[20:21], v[60:61], v[60:61] op_sel:[0,1]
    v_mov_b32 v22, v62
    v_max_f32 v124, v58, v62
    s_or_b64 vcc, vcc, s[44:45]
    s_and_b64 exec, exec, vcc
    s_cbranch_scc0 L_got2b
    global_load_dwordx4 v[56:59], v12, s[26:27] offset:0 sc1
    global_load_dwordx4 v[60:63], v12, s[26:27] offset:1024 sc1
    s_sub_u32 s35, s35, 1
    s_cbranch_scc0 L_poll2b
    s_endpgm
L_wait_a:
    s_waitcnt vmcnt(0)
    v_mfma_f32_16x16x32_bf16 v[112:115], v[32:35], v[96:99], 0
    v_mfma_f32_16x16x32_bf16 v[112:115], v[36:39], v[100:103], v[112:115]
    s_barrier
    ds_read_b128 v[40:43], v126 offset:35008
    s_bitcmp0_b32 s36, 0
    s_waitcnt lgkmcnt(0)
    v_and_b32 v16, v40, v146
    v_and_b32 v17, v40, v147
    v_and_b32 v18, v40, v148
    v_and_b32 v19, v40, v149
    v_and_b32 v20, v41, v146
    v_and_b32 v21, v41, v147
    v_and_b32 v22, v41, v148
    v_and_b32 v23, v41, v149
    v_mfma_f32_16x16x32_bf16 v[112:115], v[16:19], v[80:83], v[112:115]
    v_and_b32 v24, v42, v146
    v_and_b32 v25, v42, v147
    v_and_b32 v26, v42, v148
    v_and_b32 v27, v42, v149
    v_mfma_f32_16x16x32_bf16 v[112:115], v[20:23], v[84:87], v[112:115]
    v_and_b32 v28, v43, v146
    v_and_b32 v29, v43, v147
    v_and_b32 v30, v43, v148
    v_and_b32 v31, v43, v149
    v_mfma_f32_16x16x32_bf16 v[112:115], v[24:27], v[88:91], v[112:115]
    s_branch L_last_mfma
L_got2b:
    s_mov_b64 exec, -1
    v_max_f32_dpp v124, v124, v124 row_ror:4 row_mask:0xf bank_mask:0xf
    v_lshlrev_b32 v24, 16, v16
    v_and_b32 v25, s38, v16
    v_max_f32_dpp v124, v124, v124 row_ror:8 row_mask:0xf bank_mask:0xf
    v_mov_b32 v126, v124
    v_lshlrev_b32 v26, 16, v17
    v_and_b32 v27, s38, v17
    v_permlane16_swap_b32 v126, v124
    v_max_f32 v124, v124, v126
    v_mov_b32 v126, v124
    v_lshlrev_b32 v28, 16, v20
    v_and_b32 v29, s38, v20
    v_permlane32_swap_b32 v126, v124
    v_max_f32 v124, v124, v126
    v_sub_f32 v120, v18, v124
    v_sub_f32 v122, v22, v124
    v_exp_f32 v120, v120
    v_exp_f32 v122, v122
    v_lshlrev_b32 v30, 16, v21
    v_add_f32 v126, v120, v122
    v_and_b32_e64 v31, s38, v21
    v_pk_mul_f32 v[24:25], v[24:25], v[120:121] op_sel_hi:[1,0]
    v_add_f32_dpp v126, v126, v126 row_ror:4 row_mask:0xf bank_mask:0xf
    v_pk_mul_f32 v[26:27], v[26:27], v[120:121] op_sel_hi:[1,0]
    v_pk_fma_f32 v[24:25], v[28:29], v[122:123], v[24:25] op_sel_hi:[1,0,1]
    v_add_f32_dpp v126, v126, v126 row_ror:8 row_mask:0xf bank_mask:0xf
    v_pk_fma_f32 v[26:27], v[30:31], v[122:123], v[26:27] op_sel_hi:[1,0,1]
    v_mov_b32 v124, v126
    s_bitcmp0_b32 s36, 0
    v_permlane32_swap_b32 v24, v26
    v_permlane32_swap_b32 v25, v27
    v_permlane32_swap_b32 v124, v126
    v_pk_add_f32 v[24:25], v[24:25], v[26:27]
    v_add_f32 v126, v126, v124
    s_mov_b32 s35, 200000
    v_permlane16_swap_b32 v24, v25
    v_mov_b32 v124, v126
    v_add_f32 v24, v24, v25
    s_nop 0
    v_permlane16_swap_b32 v124, v126
    v_add_f32_dpp v24, v24, v24 row_ror:4 row_mask:0xf bank_mask:0xf
    v_add_f32 v126, v126, v124
    v_rcp_f32 v126, v126
    v_add_f32_dpp v24, v24, v24 row_ror:8 row_mask:0xf bank_mask:0xf
    v_mul_f32 v125, v24, v126
    v_cvt_pk_bf16_f32 v125, v125, v125
    ds_write_b32 v165, v125 offset:35008
    s_waitcnt lgkmcnt(0)
    s_barrier
    v_and_b32_dpp v16, v125, v146 row_newbcast:0 row_mask:0xf bank_mask:0xf
    v_and_b32_dpp v17, v125, v147 row_newbcast:0 row_mask:0xf bank_mask:0xf
    v_and_b32_dpp v18, v125, v148 row_newbcast:0 row_mask:0xf bank_mask:0xf
    v_and_b32_dpp v19, v125, v149 row_newbcast:0 row_mask:0xf bank_mask:0xf
    v_and_b32_dpp v20, v125, v146 row_newbcast:1 row_mask:0xf bank_mask:0xf
    v_and_b32_dpp v21, v125, v147 row_newbcast:1 row_mask:0xf bank_mask:0xf
    v_and_b32_dpp v22, v125, v148 row_newbcast:1 row_mask:0xf bank_mask:0xf
    v_and_b32_dpp v23, v125, v149 row_newbcast:1 row_mask:0xf bank_mask:0xf
    v_mfma_f32_16x16x32_bf16 v[112:115], v[16:19], v[80:83], v[112:115]
    v_and_b32_dpp v24, v125, v146 row_newbcast:2 row_mask:0xf bank_mask:0xf
    v_and_b32_dpp v25, v125, v147 row_newbcast:2 row_mask:0xf bank_mask:0xf
    v_and_b32_dpp v26, v125, v148 row_newbcast:2 row_mask:0xf bank_mask:0xf
    v_and_b32_dpp v27, v125, v149 row_newbcast:2 row_mask:0xf bank_mask:0xf
    v_mfma_f32_16x16x32_bf16 v[112:115], v[20:23], v[84:87], v[112:115]
    v_and_b32_dpp v28, v125, v146 row_newbcast:3 row_mask:0xf bank_mask:0xf
    v_and_b32_dpp v29, v125, v147 row_newbcast:3 row_mask:0xf bank_mask:0xf
    v_and_b32_dpp v30, v125, v148 row_newbcast:3 row_mask:0xf bank_mask:0xf
    v_and_b32_dpp v31, v125, v149 row_newbcast:3 row_mask:0xf bank_mask:0xf
    v_mfma_f32_16x16x32_bf16 v[112:115], v[24:27], v[88:91], v[112:115]
L_last_mfma:
    s_nop 1
    v_mfma_f32_16x16x32_bf16 v[112:115], v[28:31], v[92:95], v[112:115]
    s_mov_b32 exec_hi, 0
    s_nop 0
    s_nop 5
    v_perm_b32 v112, v112, v127, s56
    v_perm_b32 v113, v113, v127, s57
    v_perm_b32 v114, v114, v127, s58
    v_perm_b32 v115, v115, v127, s59
    s_cbranch_scc1 L_slow_h25
    global_store_dwordx4 v13, v[112:115], s[26:27]
L_back_h25:
    s_cmp_lg_u32 s30, 2
    s_cbranch_scc1 L_done
    s_mov_b64 exec, -1
    global_load_dwordx4 v[32:35], v14, s[26:27] sc1
    global_load_dwordx4 v[36:39], v164, s[26:27] sc1
    s_waitcnt vmcnt(2)
    global_load_dwordx4 v[40:43], v14, s[26:27] sc1
    global_load_dwordx4 v[44:47], v164, s[26:27] sc1
    s_mov_b32 s44, 0xff
    s_mov_b32 s45, s44
    s_lshr_b32 s41, s32, 2
    s_lshl_b32 s46, 0x01010101, s31
    s_not_b32 s46, s46
    s_mov_b32 s47, s46
L_poll25:
    s_waitcnt vmcnt(3)
    v_xor_b32 v16, s60, v32
    v_xor_b32 v17, s61, v33
    v_xor_b32 v18, s52, v34
    v_xor_b32 v19, s53, v35
    v_or3_b32 v124, v16, v17, v18
    s_waitcnt vmcnt(2)
    v_xor_b32 v20, s60, v36
    v_xor_b32 v21, s61, v37
    v_xor_b32 v22, s52, v38
    v_xor_b32_e64 v23, s53, v39
    v_or3_b32 v124, v124, v19, v20
    v_or3_b32 v124, v124, v21, v22
    v_or_b32_sdwa v124, v124, v23 dst_sel:DWORD dst_unused:UNUSED_PAD src0_sel:BYTE_0 src1_sel:BYTE_0
    v_cmp_ne_u32 vcc, 0, v124
    v_pk_add_f32 v[16:17], v[16:17], v[20:21]
    v_pk_add_f32 v[18:19], v[18:19], v[22:23]
    s_and_b64 exec, exec, vcc
    s_cbranch_scc0 L_got25
    global_load_dwordx4 v[32:35], v14, s[26:27] sc1
    global_load_dwordx4 v[36:39], v164, s[26:27] sc1
    s_waitcnt vmcnt(3)
    v_xor_b32 v16, s60, v40
    v_xor_b32 v17, s61, v41
    v_xor_b32 v18, s52, v42
    v_xor_b32 v19, s53, v43
    v_or3_b32 v124, v16, v17, v18
    s_waitcnt vmcnt(2)
    v_xor_b32 v20, s60, v44
    v_xor_b32 v21, s61, v45
    v_xor_b32 v22, s52, v46
    v_xor_b32_e64 v23, s53, v47
    v_or3_b32 v124, v124, v19, v20
    v_or3_b32 v124, v124, v21, v22
    v_or_b32_sdwa v124, v124, v23 dst_sel:DWORD dst_unused:UNUSED_PAD src0_sel:BYTE_0 src1_sel:BYTE_0
    v_cmp_ne_u32 vcc, 0, v124
    v_pk_add_f32 v[16:17], v[16:17], v[20:21]
    v_pk_add_f32 v[18:19], v[18:19], v[22:23]
    s_and_b64 exec, exec, vcc
    s_cbranch_scc0 L_got25
    global_load_dwordx4 v[40:43], v14, s[26:27] sc1
    global_load_dwordx4 v[44:47], v164, s[26:27] sc1
    s_sub_u32 s35, s35, 1
    s_cbranch_scc0 L_poll25
    s_endpgm
L_got25:
    s_mov_b64 exec, -1
    v_permlane32_swap_b32 v16, v18
    v_permlane32_swap_b32 v17, v19
    v_pk_add_f32 v[20:21], v[16:17], v[18:19]
    v_pk_add_f32 v[16:17], v[16:17], v[18:19]
    v_mov_b32 v19, s33
    s_cmp_eq_u32 s41, s31
    v_permlane16_swap_b32 v20, v16
    v_permlane16_swap_b32 v21, v17
    v_pk_add_f32 v[16:17], v[16:17], v[20:21]
    s_cbranch_scc1 L_final
    s_nop 0
    v_add_f32_dpp v16, v16, v16 row_ror:4 row_mask:0xf bank_mask:0xf
    v_add_f32_dpp v17, v17, v17 row_ror:4 row_mask:0xf bank_mask:0xf
    s_nop 0
    v_add_f32_dpp v16, v16, v16 row_ror:8 row_mask:0xf bank_mask:0xf
    v_add_f32_dpp v17, v17, v17 row_ror:8 row_mask:0xf bank_mask:0xf
    s_mov_b64 exec, s[44:45]
    global_store_dwordx4 v150, v[16:19], s[26:27] sc1
    s_branch L_done
L_final:
    s_mov_b64 exec, s[46:47]
    global_load_dwordx4 v[48:51], v15, s[26:27] sc1
    s_mov_b64 exec, -1
    v_add_f32_dpp v16, v16, v16 row_ror:4 row_mask:0xf bank_mask:0xf
    v_add_f32_dpp v17, v17, v17 row_ror:4 row_mask:0xf bank_mask:0xf
    s_nop 0
    v_add_f32_dpp v16, v16, v16 row_ror:8 row_mask:0xf bank_mask:0xf
    v_add_f32_dpp v17, v17, v17 row_ror:8 row_mask:0xf bank_mask:0xf
    s_nop 0
    s_mov_b32 s35, 200000
    v_mov_b32_dpp v20, v16 row_newbcast:0 row_mask:0x5 bank_mask:0x3
    v_mov_b32_dpp v21, v17 row_newbcast:0 row_mask:0x5 bank_mask:0x3
    v_mov_b32_dpp v20, v16 row_newbcast:1 row_mask:0x5 bank_mask:0xc
    v_mov_b32_dpp v21, v17 row_newbcast:1 row_mask:0x5 bank_mask:0xc
    v_mov_b32_dpp v20, v16 row_newbcast:2 row_mask:0xa bank_mask:0x3
    v_mov_b32_dpp v21, v17 row_newbcast:2 row_mask:0xa bank_mask:0x3
    v_mov_b32_dpp v20, v16 row_newbcast:3 row_mask:0xa bank_mask:0xc
    v_mov_b32_dpp v21, v17 row_newbcast:3 row_mask:0xa bank_mask:0xc
    v_lshlrev_b32 v16, 16, v1
    v_and_b32 v17, s38, v1
    v_pk_add_f32 v[20:21], v[20:21], v[16:17]
    v_lshlrev_b32 v124, 4, v0
    v_mov_b32 v24, s33
    v_mov_b32 v25, s33
    v_mov_b32 v26, s33
    v_mov_b32 v27, s33
    s_mov_b32 s44, 0x01010101
    s_mov_b32 s45, s44
    s_mov_b64 exec, s[46:47]
    global_load_dwordx4 v[52:55], v15, s[26:27] sc1
    global_load_dwordx4 v[56:59], v15, s[26:27] sc1
    global_load_dwordx4 v[60:63], v15, s[26:27] sc1
    global_load_dwordx4 v[64:67], v15, s[26:27] sc1
    global_load_dwordx4 v[68:71], v15, s[26:27] sc1
L_poll3:
    s_waitcnt vmcnt(5)
    v_cmp_ne_u32 vcc, s33, v51
    v_mov_b32 v20, v48
    v_mov_b32 v21, v49
    s_and_b64 exec, exec, vcc
    s_cbranch_scc0 L_got3
    global_load_dwordx4 v[48:51], v15, s[26:27] sc1
    s_waitcnt vmcnt(5)
    v_cmp_ne_u32 vcc, s33, v55
    v_mov_b32 v20, v52
    v_mov_b32 v21, v53
    s_and_b64 exec, exec, vcc
    s_cbranch_scc0 L_got3
    global_load_dwordx4 v[52:55], v15, s[26:27] sc1
    s_waitcnt vmcnt(5)
    v_cmp_ne_u32 vcc, s33, v59
    v_mov_b32 v20, v56
    v_mov_b32 v21, v57
    s_and_b64 exec, exec, vcc
    s_cbranch_scc0 L_got3
    global_load_dwordx4 v[56:59], v15, s[26:27] sc1
    s_waitcnt vmcnt(5)
    v_cmp_ne_u32 vcc, s33, v63
    v_mov_b32 v20, v60
    v_mov_b32 v21, v61
    s_and_b64 exec, exec, vcc
    s_cbranch_scc0 L_got3
    global_load_dwordx4 v[60:63], v15, s[26:27] sc1
    s_waitcnt vmcnt(5)
    v_cmp_ne_u32 vcc, s33, v67
    v_mov_b32 v20, v64
    v_mov_b32 v21, v65
    s_and_b64 exec, exec, vcc
    s_cbranch_scc0 L_got3
    global_load_dwordx4 v[64:67], v15, s[26:27] sc1
    s_waitcnt vmcnt(5)
    v_cmp_ne_u32 vcc, s33, v71
    v_mov_b32 v20, v68
    v_mov_b32 v21, v69
    s_and_b64 exec, exec, vcc
    s_cbranch_scc0 L_got3
    global_load_dwordx4 v[68:71], v15, s[26:27] sc1
    s_sub_u32 s35, s35, 1
    s_cbranch_scc0 L_poll3
    s_endpgm
L_got3:
    s_mov_b64 exec, -1
    v_add_f32_dpp v20, v20, v20 quad_perm:[1,0,3,2] row_mask:0xf bank_mask:0xf
    v_add_f32_dpp v21, v21, v21 quad_perm:[1,0,3,2] row_mask:0xf bank_mask:0xf
    s_cmp_lg_u32 s2, 0
    v_add_f32_dpp v20, v20, v20 quad_perm:[2,3,0,1] row_mask:0xf bank_mask:0xf
    v_add_f32_dpp v21, v21, v21 quad_perm:[2,3,0,1] row_mask:0xf bank_mask:0xf
    s_nop 0
    v_add_f32_dpp v20, v20, v20 row_half_mirror row_mask:0xf bank_mask:0xf
    v_add_f32_dpp v21, v21, v21 row_half_mirror row_mask:0xf bank_mask:0xf
    v_cvt_pk_bf16_f32 v20, v20, v21
    s_mov_b64 exec, s[44:45]
    global_store_dword v10, v20, s[22:23]
    s_cbranch_scc1 L_done
    s_mov_b64 exec, 0xff
    global_store_dwordx4 v124, v[24:27], s[26:27]
L_done:
    s_endpgm
L_slow_h2:
    global_store_dwordx4 v11, v[120:123], s[26:27] sc1
    s_branch L_back_h2
L_slow_h25:
    global_store_dwordx4 v13, v[112:115], s[26:27] sc1
    s_branch L_back_h25
L_end:
    s_endpgm
.section .rodata,"a"
.p2align 6
.amdhsa_kernel parallel_sum__sliding_block_cached__swiglu_ffn__decode_kernel
  .amdhsa_next_free_vgpr 168
  .amdhsa_next_free_sgpr 96
  .amdhsa_accum_offset 168
  .amdhsa_group_segment_fixed_size 0
  .amdhsa_kernarg_size 96
  .amdhsa_user_sgpr_count 2
  .amdhsa_user_sgpr_kernarg_segment_ptr 1
  .amdhsa_system_sgpr_workgroup_id_x 1
.end_amdhsa_kernel
```
